```python
import torch

def _softmax(x, axis=-1):
    return torch.softmax(x, dim=axis)
def _gelu(x):
    return torch.nn.functional.gelu(x, approximate="tanh")
def _silu(x):
    return torch.nn.functional.silu(x)
def _sigmoid(x):
    return torch.sigmoid(x)
def _layernorm(x, axis=-1, eps=1e-5):
    m = x.mean(dim=axis, keepdim=True)
    v = x.var(dim=axis, keepdim=True, unbiased=False)
    return (x - m) / torch.sqrt(v + eps)
def _scatter_add(tgt, idx, src, axis=0):
    return tgt.clone().index_add_(axis, idx, src)
def _segment_sum(src, seg, n):
    out = torch.zeros((n,) + src.shape[1:], dtype=src.dtype)
    return out.index_add_(0, seg, src)
def _pad(x, pw):
    flat = tuple(v for pair in reversed(pw) for v in pair)
    return torch.nn.functional.pad(x, flat)

kernel_name = 'parallel_sum__sliding_block_cached__geglu_ffn__decode'

def setup_inputs():

    _w = (lambda a: (lambda t: t.to(torch.bfloat16) if t.is_floating_point() else t)(torch.as_tensor(a)))
    def _A_setup():
        B, Sq, D = 2, 1, 640
        Hq, Hkv, Sk, Dh = 32, 32, 4096, 128
        assert Hq % Hkv == 0, (Hq, Hkv)
        return {
            "x": _w((lambda *s: torch.randn(*s, dtype=torch.bfloat16) * 0.05)(B, Sq, D)),
            "k_cache": _w((lambda *s: torch.randn(*s, dtype=torch.bfloat16) * 3.2)(B, Hkv, Sk, Dh)),
            "v_cache": _w((lambda *s: torch.randn(*s, dtype=torch.bfloat16) * 1.6)(B, Hkv, Sk, Dh)),
            "wq": _w((lambda *s: torch.randn(*s, dtype=torch.bfloat16) * 3.2)(D, Hq * Dh) * (D ** -0.5)),
            "wo": _w((lambda *s: torch.randn(*s, dtype=torch.bfloat16) * 1.6)(Hq * Dh, D) * ((Hq * Dh) ** -0.5)),
        }
    _A_in = _A_setup()

    def _B_setup():
        B, S, D, F = 2, 1, 640, 1728
        return {
            "x": _w((lambda *s: torch.randn(*s, dtype=torch.bfloat16) * 0.05)(B, S, D)),
            "w_gate": _w((lambda *s: torch.randn(*s, dtype=torch.bfloat16) * 0.05)(D, F)),
            "w_up": _w((lambda *s: torch.randn(*s, dtype=torch.bfloat16) * 0.05)(D, F)),
            "w_down": _w((lambda *s: torch.randn(*s, dtype=torch.bfloat16) * 0.05)(F, D)),
        }
    _B_in = _B_setup()

    return {
        "A_x": _A_in["x"],
        "A_k_cache": _A_in["k_cache"],
        "A_v_cache": _A_in["v_cache"],
        "A_wq": _A_in["wq"],
        "A_wo": _A_in["wo"],
        "B_x": _B_in["x"],
        "B_w_gate": _B_in["w_gate"],
        "B_w_up": _B_in["w_up"],
        "B_w_down": _B_in["w_down"],
    }

def reference(A_x, A_k_cache, A_v_cache, A_wq, A_wo, B_x, B_w_gate, B_w_up, B_w_down):
    def _A_ref(x, k_cache, v_cache, wq, wo):
        B, Sq, D = x.shape
        Hq, Dh = 32, 128
        Hkv, Sk = k_cache.shape[1], k_cache.shape[2]
        W = min(4096, max(256, Sk // 4))
        rep = Hq // Hkv
        q = (lambda x, *d: x.permute(*d))((x @ wq).reshape(B, Sq, Hq, Dh), 0, 2, 1, 3)
        k = (lambda x, n, axis: torch.repeat_interleave(x, n, dim=axis))(k_cache[:, :, Sk - W:, :], rep, axis=1)
        v = (lambda x, n, axis: torch.repeat_interleave(x, n, dim=axis))(v_cache[:, :, Sk - W:, :], rep, axis=1)
        scores = torch.einsum("bhqd,bhkd->bhqk", q, k) * (Dh ** -0.5)
        p = _softmax(scores, axis=-1)
        o = torch.einsum("bhqk,bhkd->bhqd", p, v)
        return (lambda x, *d: x.permute(*d))(o, 0, 2, 1, 3).reshape(B, Sq, Hq * Dh) @ wo

    def _B_ref(x, w_gate, w_up, w_down):
        return (_gelu(x @ w_gate) * (x @ w_up)) @ w_down

    x = A_x
    xn = _layernorm(x, axis=-1)
    return x + _A_ref(xn, A_k_cache, A_v_cache, A_wq, A_wo) + _B_ref(xn, B_w_gate, B_w_up, B_w_down)
```

```asm
; @launch grid=(256,1,1) block=(768,1,1) lds=24512
.amdgcn_target "amdgcn-amd-amdhsa--gfx950"
.text
.globl parallel_sum__sliding_block_cached__geglu_ffn__decode_kernel
.p2align 8
.type parallel_sum__sliding_block_cached__geglu_ffn__decode_kernel,@function
parallel_sum__sliding_block_cached__geglu_ffn__decode_kernel:
    s_load_dwordx16 s[4:19], s[0:1], 0
    s_load_dwordx8 s[20:27], s[0:1], 64
    s_cmp_ge_u32 s2, 256
    s_cbranch_scc1 L_end
    v_lshrrev_b32 v1, 6, v0
    s_getpc_b64 s[90:91]
    s_and_b32 s90, s90, 0xffffff00
    s_and_b32 s92, s2, 0x18
    s_cbranch_scc1 L_nocpf
    v_lshlrev_b32 v8, 4, v0
    v_cmp_ge_u32 vcc, (L_codeend-parallel_sum__sliding_block_cached__geglu_ffn__decode_kernel-16)&0xfffffff0, v8
    s_and_saveexec_b64 s[92:93], vcc
    s_cbranch_execz L_nocpf0
    global_load_dwordx4 v[160:163], v8, s[90:91]
L_nocpf0:
    s_mov_b64 exec, -1
L_nocpf:
    v_readfirstlane_b32 s3, v1
    v_and_b32 v0, 63, v0
    s_and_b32 s28, s2, 7
    s_lshr_b32 s29, s2, 6
    s_lshl3_add_u32 s28, s29, s28
    s_bfe_u32 s29, s2, 0x30003
    s_lshr_b32 s30, s29, 2
    s_and_b32 s31, s29, 3
    v_lshlrev_b32 v2, 4, v0
    s_mov_b32 s39, 0x20000
    s_cmp_lg_u32 s3, 5
    s_cbranch_scc1 L_nG
    v_and_b32 v8, 31, v0
    v_lshrrev_b32 v9, 5, v0
    v_mul_u32_u24 v12, 1280, v9
    v_lshl_add_u32 v11, v8, 4, v12
    v_lshl_add_u32 v10, v8, 3, v12
    s_mul_i32 s55, s29, 160
    s_movk_i32 s38, 2560
    s_waitcnt lgkmcnt(0)
    s_mov_b64 s[36:37], s[4:5]
    buffer_load_dwordx4 v[16:19], v11, s[36:39], 0 offen
    buffer_load_dwordx4 v[20:23], v11, s[36:39], 0 offen offset:512
    buffer_load_dwordx2 v[24:25], v10, s[36:39], 0 offen offset:1024
    buffer_load_dwordx2 v[26:27], v10, s[36:39], s55 offen
    s_branch L_G2
L_nG:
    s_sub_u32 s40, s3, 6
    s_cmp_lt_u32 s40, 4
    s_cbranch_scc1 L_A
    s_sub_u32 s40, s3, 2
    s_cmp_lt_u32 s40, 3
    s_cbranch_scc1 L_Y0
    s_and_b32 s3, s3, 3
    s_lshl_b32 s41, s28, 1
    s_add_u32 s41, s41, s3
    s_cmp_lt_u32 s3, 2
    s_cselect_b32 s41, s41, s28
    s_movk_i32 s43, 3456
    s_cmovk_i32 s43, 8192
    s_mov_b32 s38, 2211840
    s_cmov_b32 s38, 5242880
    s_cselect_b32 s42, 0, s28
    s_cmp_ge_u32 s42, 27
    s_cbranch_scc1 L_Uskip
    s_lshl_b32 s41, s41, 7
    s_lshl_b32 s40, s43, 3
    s_mul_i32 s42, s40, s29
    s_mul_i32 s42, s42, 10
    s_add_u32 s41, s41, s42
    v_lshrrev_b32 v8, 3, v0
    v_mul_lo_u32 v10, v8, s43
    v_and_b32 v9, 7, v0
    v_lshl_add_u32 v10, v9, 4, v10
    s_cmp_eq_u32 s3, 2
    s_waitcnt lgkmcnt(0)
    s_cselect_b64 s[36:37], s[16:17], s[18:19]
    s_cmp_lt_u32 s3, 2
    s_cselect_b64 s[36:37], s[10:11], s[36:37]
    s_load_dword s32, s[26:27], 0
    s_mov_b64 s[48:49], s[26:27]
    s_mov_b32 s50, 0x1f8000
    s_mov_b32 s51, 0x20000
    buffer_load_dwordx4 v[40:43], v10, s[36:39], s41 offen nt
    s_add_u32 s41, s41, s40
    buffer_load_dwordx4 v[44:47], v10, s[36:39], s41 offen nt
    s_add_u32 s41, s41, s40
    buffer_load_dwordx4 v[48:51], v10, s[36:39], s41 offen nt
    s_add_u32 s41, s41, s40
    buffer_load_dwordx4 v[52:55], v10, s[36:39], s41 offen nt
    s_add_u32 s41, s41, s40
    buffer_load_dwordx4 v[56:59], v10, s[36:39], s41 offen nt
    s_add_u32 s41, s41, s40
    buffer_load_dwordx4 v[60:63], v10, s[36:39], s41 offen nt
    s_add_u32 s41, s41, s40
    buffer_load_dwordx4 v[64:67], v10, s[36:39], s41 offen nt
    s_add_u32 s41, s41, s40
    buffer_load_dwordx4 v[68:71], v10, s[36:39], s41 offen nt
    s_add_u32 s41, s41, s40
    buffer_load_dwordx4 v[72:75], v10, s[36:39], s41 offen nt
    s_add_u32 s41, s41, s40
    buffer_load_dwordx4 v[76:79], v10, s[36:39], s41 offen nt
    s_branch L_P2
L_A:
    s_mov_b32 s3, s40
    s_lshl_b32 s46, s30, 25
    s_lshl_b32 s45, s28, 20
    s_add_u32 s46, s46, s45
    s_add_u32 s46, s46, 786432
    s_lshl_b32 s45, s31, 16
    s_add_u32 s52, s46, s45
    s_lshr_b32 s53, s2, 3
    s_mul_i32 s53, s53, 24
    s_and_b32 s45, s2, 7
    s_mul_i32 s45, s45, 11
    s_add_u32 s53, s53, s45
    s_lshr_b32 s53, s53, 2
    s_add_u32 s53, s53, s3
    s_lshl_b32 s44, s53, 12
    s_movk_i32 s47, 0x4000
    s_mov_b32 s45, 0xffff
    s_and_b32 s44, s44, s45
    s_mov_b32 s38, 0x10000
    s_waitcnt lgkmcnt(0)
    s_add_u32 s36, s6, s52
    s_addc_u32 s37, s7, 0
    s_load_dword s32, s[26:27], 0
    s_mov_b64 s[48:49], s[26:27]
    s_mov_b32 s50, 0x1f8000
    s_mov_b32 s51, 0x20000
    buffer_load_dwordx4 v[32:35], v2, s[36:39], s44 offen offset:0 nt
    buffer_load_dwordx4 v[36:39], v2, s[36:39], s44 offen offset:1024 nt
    buffer_load_dwordx4 v[40:43], v2, s[36:39], s44 offen offset:2048 nt
    buffer_load_dwordx4 v[44:47], v2, s[36:39], s44 offen offset:3072 nt
    s_add_u32 s44, s44, s47
    s_and_b32 s44, s44, s45
    s_branch L_A2
L_G2:
    v_mul_u32_u24 v11, 1600, v9
    s_movk_i32 s40, 80
    v_mad_u32_u24 v11, v8, s40, v11
    s_load_dword s32, s[26:27], 0
    s_mov_b64 s[48:49], s[26:27]
    s_mov_b32 s50, 0x1f8000
    s_mov_b32 s51, 0x20000
    v_and_b32 v4, 3, v0
    v_mul_u32_u24 v4, 0x5555, v4
    s_mov_b32 s34, 15
    s_mov_b32 s35, 0xffff0000
    v_mov_b32 v14, 256
    v_mov_b32 v15, 1
    v_mov_b32 v28, 0
    v_mov_b32 v29, 0
    v_mov_b32 v30, 0
    v_mov_b32 v31, 0
    ds_write_b128 v2, v[28:31] offset:256
    ds_write_b128 v2, v[28:31] offset:1280
    ds_write_b128 v2, v[28:31] offset:2304
    ds_write_b128 v2, v[28:31] offset:3328
    v_mov_b32 v60, 0x3acccccd
    s_waitcnt vmcnt(1)
    v_lshlrev_b32 v40, 16, v16
    v_and_b32 v41, s35, v16
    v_lshlrev_b32 v42, 16, v17
    v_and_b32 v43, s35, v17
    v_lshlrev_b32 v44, 16, v18
    v_and_b32 v45, s35, v18
    v_lshlrev_b32 v46, 16, v19
    v_and_b32 v47, s35, v19
    v_lshlrev_b32 v48, 16, v20
    v_and_b32 v49, s35, v20
    v_lshlrev_b32 v50, 16, v21
    v_and_b32 v51, s35, v21
    v_lshlrev_b32 v52, 16, v22
    v_and_b32 v53, s35, v22
    v_lshlrev_b32 v54, 16, v23
    v_and_b32 v55, s35, v23
    v_lshlrev_b32 v56, 16, v24
    v_and_b32 v57, s35, v24
    v_lshlrev_b32 v58, 16, v25
    v_and_b32 v59, s35, v25
    v_pk_add_f32 v[28:29], v[40:41], v[42:43]
    v_pk_add_f32 v[30:31], v[44:45], v[46:47]
    v_pk_add_f32 v[28:29], v[28:29], v[48:49]
    v_pk_add_f32 v[30:31], v[30:31], v[50:51]
    v_pk_add_f32 v[28:29], v[28:29], v[52:53]
    v_pk_add_f32 v[30:31], v[30:31], v[54:55]
    v_pk_add_f32 v[28:29], v[28:29], v[56:57]
    v_pk_add_f32 v[30:31], v[30:31], v[58:59]
    v_pk_add_f32 v[28:29], v[28:29], v[30:31]
    v_add_f32 v28, v28, v29
    s_nop 1
    v_add_f32_dpp v28, v28, v28 row_ror:8 row_mask:0xf bank_mask:0xf
    s_nop 1
    v_add_f32_dpp v28, v28, v28 row_ror:4 row_mask:0xf bank_mask:0xf
    s_nop 1
    v_add_f32_dpp v28, v28, v28 row_ror:2 row_mask:0xf bank_mask:0xf
    s_nop 1
    v_add_f32_dpp v28, v28, v28 row_ror:1 row_mask:0xf bank_mask:0xf
    v_mov_b32 v29, v28
    s_nop 1
    v_permlane16_swap_b32 v28, v29
    v_add_f32 v28, v28, v29
    v_mul_f32 v36, v28, v60
    v_mul_f32 v37, v28, v60
    v_pk_add_f32 v[40:41], v[40:41], v[36:37] neg_lo:[0,1] neg_hi:[0,1]
    v_pk_add_f32 v[42:43], v[42:43], v[36:37] neg_lo:[0,1] neg_hi:[0,1]
    v_pk_add_f32 v[44:45], v[44:45], v[36:37] neg_lo:[0,1] neg_hi:[0,1]
    v_pk_add_f32 v[46:47], v[46:47], v[36:37] neg_lo:[0,1] neg_hi:[0,1]
    v_pk_add_f32 v[48:49], v[48:49], v[36:37] neg_lo:[0,1] neg_hi:[0,1]
    v_pk_add_f32 v[50:51], v[50:51], v[36:37] neg_lo:[0,1] neg_hi:[0,1]
    v_pk_add_f32 v[52:53], v[52:53], v[36:37] neg_lo:[0,1] neg_hi:[0,1]
    v_pk_add_f32 v[54:55], v[54:55], v[36:37] neg_lo:[0,1] neg_hi:[0,1]
    v_pk_add_f32 v[56:57], v[56:57], v[36:37] neg_lo:[0,1] neg_hi:[0,1]
    v_pk_add_f32 v[58:59], v[58:59], v[36:37] neg_lo:[0,1] neg_hi:[0,1]
    v_pk_mul_f32 v[28:29], v[40:41], v[40:41]
    v_pk_mul_f32 v[30:31], v[42:43], v[42:43]
    v_pk_fma_f32 v[28:29], v[44:45], v[44:45], v[28:29]
    v_pk_fma_f32 v[30:31], v[46:47], v[46:47], v[30:31]
    v_pk_fma_f32 v[28:29], v[48:49], v[48:49], v[28:29]
    v_pk_fma_f32 v[30:31], v[50:51], v[50:51], v[30:31]
    v_pk_fma_f32 v[28:29], v[52:53], v[52:53], v[28:29]
    v_pk_fma_f32 v[30:31], v[54:55], v[54:55], v[30:31]
    v_pk_fma_f32 v[28:29], v[56:57], v[56:57], v[28:29]
    v_pk_fma_f32 v[30:31], v[58:59], v[58:59], v[30:31]
    v_pk_add_f32 v[28:29], v[28:29], v[30:31]
    v_add_f32 v28, v28, v29
    v_cvt_pk_bf16_f32 v36, v36, v36
    v_and_b32 v36, s35, v36
    s_waitcnt vmcnt(0)
    v_lshlrev_b32 v32, 16, v26
    v_and_b32 v33, s35, v26
    v_lshlrev_b32 v34, 16, v27
    v_and_b32 v35, s35, v27
    v_add_f32_dpp v28, v28, v28 row_ror:8 row_mask:0xf bank_mask:0xf
    s_nop 1
    v_add_f32_dpp v28, v28, v28 row_ror:4 row_mask:0xf bank_mask:0xf
    s_nop 1
    v_add_f32_dpp v28, v28, v28 row_ror:2 row_mask:0xf bank_mask:0xf
    s_nop 1
    v_add_f32_dpp v28, v28, v28 row_ror:1 row_mask:0xf bank_mask:0xf
    v_mov_b32 v29, v28
    s_nop 1
    v_permlane16_swap_b32 v28, v29
    v_add_f32 v28, v28, v29
    v_mul_f32 v31, v28, v60
    v_sub_f32 v32, v32, v36
    v_sub_f32 v33, v33, v36
    v_sub_f32 v34, v34, v36
    v_sub_f32 v35, v35, v36
    v_cvt_pk_bf16_f32 v31, v31, v31
    v_and_b32 v31, s35, v31
    v_cvt_pk_bf16_f32 v33, v32, v33
    v_cvt_pk_bf16_f32 v35, v34, v35
    v_add_f32 v31, 0x3727c5ac, v31
    v_cvt_pk_bf16_f32 v31, v31, v31
    v_and_b32 v31, s35, v31
    v_sqrt_f32 v31, v31
    v_lshlrev_b32 v32, 16, v33
    v_and_b32 v33, s35, v33
    v_lshlrev_b32 v34, 16, v35
    v_and_b32 v35, s35, v35
    v_cvt_pk_bf16_f32 v31, v31, v31
    v_and_b32 v31, s35, v31
    v_rcp_f32 v31, v31
    s_nop 0
    v_mul_f32 v32, v32, v31
    v_mul_f32 v33, v33, v31
    v_mul_f32 v34, v34, v31
    v_mul_f32 v35, v35, v31
    v_cvt_pk_bf16_f32 v32, v32, 0
    v_cvt_pk_bf16_f32 v33, v33, 0
    v_cvt_pk_bf16_f32 v34, v34, 0
    v_cvt_pk_bf16_f32 v35, v35, 0
    s_mov_b32 exec_lo, 0xfffff
    s_mov_b32 exec_hi, 0xfffff
    ds_write2_b32 v11, v32, v34 offset0:160 offset1:162
    ds_write2_b32 v11, v32, v34 offset0:165 offset1:167
    ds_write2_b32 v11, v33, v35 offset0:168 offset1:170
    ds_write2_b32 v11, v33, v35 offset0:173 offset1:175
    s_mov_b64 exec, -1
    s_waitcnt lgkmcnt(0)
    s_barrier
    s_sub_u32 s88, s28, 27
    s_lshl3_add_u32 s88, s88, s29
    s_add_u32 s32, s32, 1
    s_and_b32 s33, s32, 15
    v_mov_b32 v3, s33
    s_getreg_b32 s52, hwreg(HW_REG_XCC_ID, 0, 4)
    s_lshl_b32 s53, s32, 4
    s_or_b32 s52, s52, s53
    v_mov_b32 v32, s52
    v_mov_b32 v33, s52
    v_mov_b32 v34, s52
    v_mov_b32 v35, s52
    s_lshl_b32 s55, s28, 7
    s_add_u32 s55, s55, 4096
    s_lshl_b32 s53, s29, 4
    s_add_u32 s53, s53, s55
    s_mov_b32 s47, s53
    s_mov_b64 exec, 1
    buffer_store_dwordx4 v[32:35], v2, s[48:51], s47 offen
    s_mov_b64 exec, -1
    s_lshl_b32 s54, s28, 13
    s_lshl_b32 s42, s30, 12
    s_add_u32 s56, s54, s42
    s_add_u32 s54, s56, 8192
    v_bfe_u32 v12, v0, 4, 1
    v_lshlrev_b32 v12, 7, v12
    v_and_b32 v9, 7, v0
    v_lshl_add_u32 v12, v9, 4, v12
    v_lshlrev_b32 v13, 4, v9
    v_bfe_u32 v9, v0, 3, 1
    v_lshl_add_u32 v12, v9, 3, v12
    v_lshrrev_b32 v9, 5, v0
    v_lshl_add_u32 v12, v9, 2, v12
    s_mov_b32 s60, 0
    s_mov_b32 s53, -1
    s_add_u32 s56, s56, 491520
    s_lshr_b32 s42, s31, 1
    s_lshl_b32 s42, s42, 11
    s_add_u32 s57, s56, s42
    s_xor_b32 s42, s42, 2048
    s_add_u32 s56, s56, s42
    s_and_b32 s42, s32, 0xffff
    v_mov_b32 v10, s42
    s_mov_b32 s58, 0xffff
    s_lshr_b32 s59, s2, 3
    s_mul_i32 s59, s59, 24
    s_and_b32 s42, s2, 7
    s_mul_i32 s42, s42, 11
    s_add_u32 s59, s59, s42
    s_lshr_b32 s59, s59, 2
    s_lshl_b32 s59, s59, 1
    s_movk_i32 s40, 80
    s_movk_i32 s41, 2576
    v_lshrrev_b32 v9, 1, v0
    v_subrev_u32 v9, s59, v9
    v_bfe_u32 v8, v9, 3, 3
    v_and_b32 v11, 1, v9
    v_lshl_add_u32 v8, v8, 1, v11
    v_and_b32 v11, 1, v0
    v_lshl_add_u32 v8, v8, 1, v11
    v_mul_u32_u24 v8, s40, v8
    v_bfe_u32 v9, v9, 1, 2
    v_mad_u32_u24 v8, v9, s41, v8
    v_add_u32 v18, 13696, v8
    v_lshrrev_b32 v9, 1, v0
    v_subrev_u32 v9, s59, v9
    v_add_u32 v9, 32, v9
    v_bfe_u32 v8, v9, 3, 3
    v_and_b32 v11, 1, v9
    v_lshl_add_u32 v8, v8, 1, v11
    v_and_b32 v11, 1, v0
    v_lshl_add_u32 v8, v8, 1, v11
    v_mul_u32_u24 v8, s40, v8
    v_bfe_u32 v9, v9, 1, 2
    v_mad_u32_u24 v8, v9, s41, v8
    v_add_u32 v19, 13696, v8
L_Gw:
    ds_read_b32 v5, v14 offset:28
    s_waitcnt lgkmcnt(0)
    v_cmp_gt_u32 vcc, 2, v5
    s_cbranch_vccz L_Gw_ok
    s_sleep 1
    s_branch L_Gw
L_Gw_ok:
L_Gq_p:
    buffer_load_dwordx4 v[40:43], v2, s[48:51], s54 offen offset:0 nt
    buffer_load_dwordx4 v[44:47], v2, s[48:51], s54 offen offset:1024 nt
    buffer_load_dwordx4 v[48:51], v2, s[48:51], s54 offen offset:2048 nt
    buffer_load_dwordx4 v[52:55], v2, s[48:51], s54 offen offset:3072 nt
    buffer_load_dword v56, v13, s[48:51], s55 offen nt
L_Gq_c:
    s_waitcnt vmcnt(0)
    v_xor_b32 v56, s52, v56
    v_and_b32 v56, s53, v56
    v_xor_b32 v40, v40, v3
    v_xor_b32 v41, v41, v3
    v_xor_b32 v42, v42, v3
    v_xor_b32 v43, v43, v3
    v_xor_b32 v44, v44, v3
    v_xor_b32 v45, v45, v3
    v_xor_b32 v46, v46, v3
    v_xor_b32 v47, v47, v3
    v_xor_b32 v48, v48, v3
    v_xor_b32 v49, v49, v3
    v_xor_b32 v50, v50, v3
    v_xor_b32 v51, v51, v3
    v_xor_b32 v52, v52, v3
    v_xor_b32 v53, v53, v3
    v_xor_b32 v54, v54, v3
    v_xor_b32 v55, v55, v3
    v_or_b32 v16, v40, v41
    v_or3_b32 v16, v42, v43, v16
    v_or3_b32 v16, v44, v45, v16
    v_or3_b32 v16, v46, v47, v16
    v_or3_b32 v16, v48, v49, v16
    v_or3_b32 v16, v50, v51, v16
    v_or3_b32 v16, v52, v53, v16
    v_or3_b32 v16, v54, v55, v16
    v_and_b32 v16, s34, v16
    v_or_b32 v16, v16, v56
    v_cmp_ne_u32 vcc, 0, v16
    s_cbranch_vccnz L_Gq_f
L_Gq_ok:
    v_pk_add_f32 v[40:41], v[40:41], v[44:45]
    v_pk_add_f32 v[42:43], v[42:43], v[46:47]
    v_pk_add_f32 v[48:49], v[48:49], v[52:53]
    v_pk_add_f32 v[50:51], v[50:51], v[54:55]
    v_pk_add_f32 v[40:41], v[40:41], v[48:49]
    v_pk_add_f32 v[42:43], v[42:43], v[50:51]
    s_nop 1
    v_permlane32_swap_b32 v40, v42
    v_permlane32_swap_b32 v41, v43
    v_add_f32 v40, v40, v42
    v_add_f32 v41, v41, v43
    v_cvt_pk_bf16_f32 v40, v40, v41
    ds_write_b32 v12, v40 offset:0
    ds_write2_b32 v14, v15, v15 offset0:0 offset1:3
    s_cmp_lt_u32 s60, 200
    s_cselect_b32 s60, 0, 200
    v_mov_b32 v32, 0x3fb8aa3b
    v_mov_b32 v33, v32
L_Gs0:
    ds_read_b32 v5, v14 offset:16
    s_waitcnt lgkmcnt(0)
    v_cmp_gt_u32 vcc, 4, v5
    s_cbranch_vccz L_Gs0_ok
    s_sleep 1
    s_branch L_Gs0
L_Gs0_ok:
L_Gs_p:
    buffer_load_dwordx4 v[40:43], v2, s[48:51], s57 offen offset:0 nt
    buffer_load_dwordx4 v[44:47], v2, s[48:51], s57 offen offset:1024 nt
    buffer_load_dwordx4 v[48:51], v2, s[48:51], s56 offen offset:0 nt
    buffer_load_dwordx4 v[52:55], v2, s[48:51], s56 offen offset:1024 nt
L_Gs_c:
    s_waitcnt vmcnt(0)
    v_xor_b32 v40, v40, v10
    v_xor_b32 v41, v41, v10
    v_xor_b32 v42, v42, v10
    v_xor_b32 v43, v43, v10
    v_xor_b32 v44, v44, v10
    v_xor_b32 v45, v45, v10
    v_xor_b32 v46, v46, v10
    v_xor_b32 v47, v47, v10
    v_xor_b32 v48, v48, v10
    v_xor_b32 v49, v49, v10
    v_xor_b32 v50, v50, v10
    v_xor_b32 v51, v51, v10
    v_xor_b32 v52, v52, v10
    v_xor_b32 v53, v53, v10
    v_xor_b32 v54, v54, v10
    v_xor_b32 v55, v55, v10
    v_or_b32 v16, v40, v41
    v_or3_b32 v16, v42, v43, v16
    v_or3_b32 v16, v44, v45, v16
    v_or3_b32 v16, v46, v47, v16
    v_or3_b32 v16, v48, v49, v16
    v_or3_b32 v16, v50, v51, v16
    v_or3_b32 v16, v52, v53, v16
    v_or3_b32 v16, v54, v55, v16
    v_and_b32 v16, s58, v16
    v_cmp_ne_u32 vcc, 0, v16
    s_cbranch_vccnz L_Gs_f
L_Gs_ok:
    v_max3_f32 v16, v40, v41, v42
    v_max3_f32 v17, v43, v44, v45
    v_max3_f32 v16, v16, v46, v47
    v_max3_f32 v17, v17, v48, v49
    v_max3_f32 v16, v16, v50, v51
    v_max3_f32 v17, v17, v52, v53
    v_max3_f32 v16, v16, v54, v55
    v_max_f32 v16, v16, v17
    s_nop 1
    v_max_f32_dpp v16, v16, v16 row_ror:8 row_mask:0xf bank_mask:0xf
    s_nop 1
    v_max_f32_dpp v16, v16, v16 row_ror:4 row_mask:0xf bank_mask:0xf
    s_nop 1
    v_max_f32_dpp v16, v16, v16 row_ror:2 row_mask:0xf bank_mask:0xf
    s_nop 1
    v_max_f32_dpp v16, v16, v16 row_ror:1 row_mask:0xf bank_mask:0xf
    s_nop 1
    v_max_f32_dpp v16, v16, v16 row_bcast:15 row_mask:0xa bank_mask:0xf
    s_nop 1
    v_max_f32_dpp v16, v16, v16 row_bcast:31 row_mask:0xc bank_mask:0xf
    s_nop 0
    v_readlane_b32 s61, v16, 63
    s_nop 1
    v_mov_b32 v20, s61
    v_mov_b32 v21, s61
    v_pk_add_f32 v[40:41], v[40:41], v[20:21] neg_lo:[0,1] neg_hi:[0,1]
    v_pk_add_f32 v[42:43], v[42:43], v[20:21] neg_lo:[0,1] neg_hi:[0,1]
    v_pk_add_f32 v[44:45], v[44:45], v[20:21] neg_lo:[0,1] neg_hi:[0,1]
    v_pk_add_f32 v[46:47], v[46:47], v[20:21] neg_lo:[0,1] neg_hi:[0,1]
    v_pk_mul_f32 v[40:41], v[40:41], v[32:33]
    v_pk_mul_f32 v[42:43], v[42:43], v[32:33]
    v_pk_mul_f32 v[44:45], v[44:45], v[32:33]
    v_pk_mul_f32 v[46:47], v[46:47], v[32:33]
    v_exp_f32 v40, v40
    v_exp_f32 v41, v41
    v_exp_f32 v42, v42
    v_exp_f32 v43, v43
    v_exp_f32 v44, v44
    v_exp_f32 v45, v45
    v_exp_f32 v46, v46
    v_exp_f32 v47, v47
    v_cvt_pk_bf16_f32 v24, v40, 0
    v_cvt_pk_bf16_f32 v25, v41, 0
    v_cvt_pk_bf16_f32 v26, v42, 0
    v_cvt_pk_bf16_f32 v27, v43, 0
    v_cvt_pk_bf16_f32 v28, v44, 0
    v_cvt_pk_bf16_f32 v29, v45, 0
    v_cvt_pk_bf16_f32 v30, v46, 0
    v_cvt_pk_bf16_f32 v31, v47, 0
    ds_write2_b32 v18, v24, v26 offset0:0 offset1:2
    ds_write2_b32 v18, v24, v26 offset0:5 offset1:7
    ds_write2_b32 v18, v25, v27 offset0:8 offset1:10
    ds_write2_b32 v18, v25, v27 offset0:13 offset1:15
    ds_write2_b32 v19, v28, v30 offset0:0 offset1:2
    ds_write2_b32 v19, v28, v30 offset0:5 offset1:7
    ds_write2_b32 v19, v29, v31 offset0:8 offset1:10
    ds_write2_b32 v19, v29, v31 offset0:13 offset1:15
    ds_write_b32 v14, v15 offset:24
    v_pk_add_f32 v[48:49], v[48:49], v[20:21] neg_lo:[0,1] neg_hi:[0,1]
    v_pk_add_f32 v[50:51], v[50:51], v[20:21] neg_lo:[0,1] neg_hi:[0,1]
    v_pk_add_f32 v[52:53], v[52:53], v[20:21] neg_lo:[0,1] neg_hi:[0,1]
    v_pk_add_f32 v[54:55], v[54:55], v[20:21] neg_lo:[0,1] neg_hi:[0,1]
    v_pk_mul_f32 v[48:49], v[48:49], v[32:33]
    v_pk_mul_f32 v[50:51], v[50:51], v[32:33]
    v_pk_mul_f32 v[52:53], v[52:53], v[32:33]
    v_pk_mul_f32 v[54:55], v[54:55], v[32:33]
    v_exp_f32 v48, v48
    v_exp_f32 v49, v49
    v_exp_f32 v50, v50
    v_exp_f32 v51, v51
    v_exp_f32 v52, v52
    v_exp_f32 v53, v53
    v_exp_f32 v54, v54
    v_exp_f32 v55, v55
    v_pk_add_f32 v[16:17], v[40:41], v[42:43]
    v_pk_add_f32 v[22:23], v[44:45], v[46:47]
    v_pk_add_f32 v[16:17], v[16:17], v[48:49]
    v_pk_add_f32 v[22:23], v[22:23], v[50:51]
    v_pk_add_f32 v[16:17], v[16:17], v[52:53]
    v_pk_add_f32 v[22:23], v[22:23], v[54:55]
    v_pk_add_f32 v[16:17], v[16:17], v[22:23]
    v_add_f32 v16, v16, v17
    s_nop 1
    v_add_f32_dpp v16, v16, v16 row_ror:8 row_mask:0xf bank_mask:0xf
    s_nop 1
    v_add_f32_dpp v16, v16, v16 row_ror:4 row_mask:0xf bank_mask:0xf
    s_nop 1
    v_add_f32_dpp v16, v16, v16 row_ror:2 row_mask:0xf bank_mask:0xf
    s_nop 1
    v_add_f32_dpp v16, v16, v16 row_ror:1 row_mask:0xf bank_mask:0xf
    s_nop 1
    v_add_f32_dpp v16, v16, v16 row_bcast:15 row_mask:0xa bank_mask:0xf
    s_nop 1
    v_add_f32_dpp v16, v16, v16 row_bcast:31 row_mask:0xc bank_mask:0xf
    s_nop 0
    v_readlane_b32 s61, v16, 63
    s_nop 1
    v_rcp_f32 v17, s61
    s_nop 0
    ds_write_b32 v14, v17 offset:36
    s_waitcnt lgkmcnt(0)
    s_endpgm
L_A2:
    v_and_b32 v4, 3, v0
    v_mul_u32_u24 v4, 0x5555, v4
    s_mov_b32 s34, 15
    s_mov_b32 s35, 0xffff0000
    v_mov_b32 v14, 256
    v_mov_b32 v15, 1
    s_lshr_b32 s52, s31, 1
    s_lshl_b32 s52, s52, 17
    s_add_u32 s46, s46, s52
    s_and_b32 s52, s31, 1
    s_lshl_b32 s52, s52, 7
    s_add_u32 s46, s46, s52
    s_add_u32 s40, s8, s46
    s_addc_u32 s41, s9, 0
    s_mov_b32 s42, 0x1ff80
    s_mov_b32 s43, 0x20000
    s_mov_b32 s61, 0x1ffff
    s_lshl_b32 s55, s53, 12
    s_and_b32 s55, s55, s61
    v_lshrrev_b32 v8, 3, v0
    v_lshlrev_b32 v13, 8, v8
    v_and_b32 v9, 7, v0
    v_lshl_add_u32 v13, v9, 4, v13
    v_bfe_u32 v9, v0, 2, 2
    v_lshlrev_b32 v9, 2, v9
    v_add_u32 v9, s53, v9
    v_and_b32 v9, 15, v9
    v_lshlrev_b32 v12, 6, v9
    v_and_b32 v9, 3, v0
    v_lshl_add_u32 v12, v9, 4, v12
    v_lshrrev_b32 v9, 4, v0
    v_lshl_add_u32 v12, v9, 2, v12
    s_lshl_b32 s54, s28, 3
    s_add_u32 s54, s54, s29
    s_lshl_b32 s54, s54, 10
    s_add_u32 s54, s54, 491520
    s_mov_b32 s56, 0xcccccccc
    s_mov_b32 s57, s56
    s_mov_b32 s58, 0xaaaaaaaa
    s_mov_b32 s59, s58
    v_mov_b32 v16, 0
    v_mov_b32 v17, 0
    v_mov_b32 v18, 0
    v_mov_b32 v19, 0
    s_mul_i32 s52, s3, 2576
    v_add_u32 v6, s52, v2
    ds_write_b128 v6, v[16:19] offset:13696
    ds_write_b128 v6, v[16:19] offset:14720
    ds_write_b128 v6, v[16:19] offset:15744
    v_lshrrev_b32 v6, 2, v0
    v_lshrrev_b32 v7, 4, v0
    v_add_lshl_u32 v6, v6, v7, 4
    v_add_u32 v6, s52, v6
    v_lshrrev_b32 v7, 5, v0
    v_lshlrev_b32 v7, 8, v7
    v_and_b32 v8, 7, v0
    v_lshl_add_u32 v7, v8, 5, v7
    v_bfe_u32 v8, v0, 4, 1
    v_lshl_add_u32 v7, v8, 4, v7
    s_lshl_b32 s52, s3, 9
    v_add_u32 v7, s52, v7
    v_and_b32 v31, 15, v0
    v_lshlrev_b32 v31, 4, v31
    s_waitcnt lgkmcnt(0)
    s_barrier
    s_sub_u32 s88, s28, 27
    s_lshl3_add_u32 s88, s88, s29
    s_add_u32 s32, s32, 1
    s_and_b32 s33, s32, 15
    v_mov_b32 v3, s33
    s_waitcnt vmcnt(3)
    buffer_load_dwordx4 v[48:51], v2, s[36:39], s44 offen offset:0 nt
    s_waitcnt vmcnt(3)
    buffer_load_dwordx4 v[52:55], v2, s[36:39], s44 offen offset:1024 nt
    s_waitcnt vmcnt(3)
    buffer_load_dwordx4 v[56:59], v2, s[36:39], s44 offen offset:2048 nt
    s_waitcnt vmcnt(3)
    buffer_load_dwordx4 v[60:63], v2, s[36:39], s44 offen offset:3072 nt
    s_add_u32 s44, s44, s47
    s_and_b32 s44, s44, s45
    s_mov_b64 exec, 1
    ds_add_u32 v14, v15 offset:8
    s_mov_b64 exec, -1
    s_waitcnt vmcnt(3)
    buffer_load_dwordx4 v[64:67], v2, s[36:39], s44 offen offset:0 nt
    s_waitcnt vmcnt(3)
    buffer_load_dwordx4 v[68:71], v2, s[36:39], s44 offen offset:1024 nt
    s_waitcnt vmcnt(3)
    buffer_load_dwordx4 v[72:75], v2, s[36:39], s44 offen offset:2048 nt
    s_waitcnt vmcnt(3)
    buffer_load_dwordx4 v[76:79], v2, s[36:39], s44 offen offset:3072 nt
    s_add_u32 s44, s44, s47
    s_and_b32 s44, s44, s45
    s_waitcnt vmcnt(3)
    buffer_load_dwordx4 v[80:83], v2, s[36:39], s44 offen offset:0 nt
    s_waitcnt vmcnt(3)
    buffer_load_dwordx4 v[84:87], v2, s[36:39], s44 offen offset:1024 nt
    s_waitcnt vmcnt(3)
    buffer_load_dwordx4 v[88:91], v2, s[36:39], s44 offen offset:2048 nt
    s_waitcnt vmcnt(3)
    buffer_load_dwordx4 v[92:95], v2, s[36:39], s44 offen offset:3072 nt
L_Aq:
    ds_read_b32 v5, v14 offset:0
    ds_read_b128 v[8:11], v31 offset:0
    s_waitcnt lgkmcnt(0)
    v_cmp_eq_u32 vcc, 0, v5
    s_cbranch_vccz L_Aq_ok
    s_sleep 1
    s_branch L_Aq
L_Aq_ok:
    v_readfirstlane_b32 s63, v5
    v_dot2_f32_bf16 v16, v32, v8, 0
    v_dot2_f32_bf16 v17, v36, v8, 0
    v_dot2_f32_bf16 v18, v40, v8, 0
    v_dot2_f32_bf16 v19, v44, v8, 0
    v_dot2c_f32_bf16 v16, v33, v9
    v_dot2c_f32_bf16 v17, v37, v9
    v_dot2c_f32_bf16 v18, v41, v9
    v_dot2c_f32_bf16 v19, v45, v9
    v_dot2c_f32_bf16 v16, v34, v10
    v_dot2c_f32_bf16 v17, v38, v10
    v_dot2c_f32_bf16 v18, v42, v10
    v_dot2c_f32_bf16 v19, v46, v10
    v_dot2c_f32_bf16 v16, v35, v11
    v_dot2c_f32_bf16 v17, v39, v11
    v_dot2c_f32_bf16 v18, v43, v11
    v_dot2c_f32_bf16 v19, v47, v11
    v_dot2_f32_bf16 v20, v48, v8, 0
    v_dot2_f32_bf16 v21, v52, v8, 0
    v_dot2_f32_bf16 v22, v56, v8, 0
    v_dot2_f32_bf16 v23, v60, v8, 0
    v_dot2c_f32_bf16 v20, v49, v9
    v_dot2c_f32_bf16 v21, v53, v9
    v_dot2c_f32_bf16 v22, v57, v9
    v_dot2c_f32_bf16 v23, v61, v9
    v_dot2c_f32_bf16 v20, v50, v10
    v_dot2c_f32_bf16 v21, v54, v10
    v_dot2c_f32_bf16 v22, v58, v10
    v_dot2c_f32_bf16 v23, v62, v10
    v_dot2c_f32_bf16 v20, v51, v11
    v_dot2c_f32_bf16 v21, v55, v11
    v_dot2c_f32_bf16 v22, v59, v11
    v_dot2c_f32_bf16 v23, v63, v11
    v_dot2_f32_bf16 v24, v64, v8, 0
    v_dot2_f32_bf16 v25, v68, v8, 0
    v_dot2_f32_bf16 v26, v72, v8, 0
    v_dot2_f32_bf16 v27, v76, v8, 0
    v_dot2c_f32_bf16 v24, v65, v9
    v_dot2c_f32_bf16 v25, v69, v9
    v_dot2c_f32_bf16 v26, v73, v9
    v_dot2c_f32_bf16 v27, v77, v9
    v_dot2c_f32_bf16 v24, v66, v10
    v_dot2c_f32_bf16 v25, v70, v10
    v_dot2c_f32_bf16 v26, v74, v10
    v_dot2c_f32_bf16 v27, v78, v10
    v_dot2c_f32_bf16 v24, v67, v11
    v_dot2c_f32_bf16 v25, v71, v11
    v_dot2c_f32_bf16 v26, v75, v11
    v_dot2c_f32_bf16 v27, v79, v11
    s_waitcnt vmcnt(3)
    buffer_load_dwordx4 v[96:99], v13, s[40:43], s55 offen offset:0 nt
    s_waitcnt vmcnt(3)
    buffer_load_dwordx4 v[100:103], v13, s[40:43], s55 offen offset:2048 nt
    s_add_u32 s55, s55, s47
    s_and_b32 s55, s55, s61
    s_waitcnt vmcnt(3)
    buffer_load_dwordx4 v[104:107], v13, s[40:43], s55 offen offset:0 nt
    s_waitcnt vmcnt(3)
    buffer_load_dwordx4 v[108:111], v13, s[40:43], s55 offen offset:2048 nt
    s_add_u32 s55, s55, s47
    s_and_b32 s55, s55, s61
    s_waitcnt vmcnt(4)
    v_dot2_f32_bf16 v28, v80, v8, 0
    v_dot2_f32_bf16 v29, v84, v8, 0
    v_dot2_f32_bf16 v30, v88, v8, 0
    v_dot2_f32_bf16 v31, v92, v8, 0
    v_dot2c_f32_bf16 v28, v81, v9
    v_dot2c_f32_bf16 v29, v85, v9
    v_dot2c_f32_bf16 v30, v89, v9
    v_dot2c_f32_bf16 v31, v93, v9
    v_dot2c_f32_bf16 v28, v82, v10
    v_dot2c_f32_bf16 v29, v86, v10
    v_dot2c_f32_bf16 v30, v90, v10
    v_dot2c_f32_bf16 v31, v94, v10
    v_dot2c_f32_bf16 v28, v83, v11
    v_dot2c_f32_bf16 v29, v87, v11
    v_dot2c_f32_bf16 v30, v91, v11
    v_dot2c_f32_bf16 v31, v95, v11
    v_add_f32_dpp v16, v16, v16 row_ror:8 row_mask:0xf bank_mask:0x3
    v_add_f32_dpp v17, v17, v17 row_ror:8 row_mask:0xf bank_mask:0x3
    v_add_f32_dpp v18, v18, v18 row_ror:8 row_mask:0xf bank_mask:0x3
    v_add_f32_dpp v19, v19, v19 row_ror:8 row_mask:0xf bank_mask:0x3
    v_add_f32_dpp v20, v20, v20 row_ror:8 row_mask:0xf bank_mask:0x3
    v_add_f32_dpp v21, v21, v21 row_ror:8 row_mask:0xf bank_mask:0x3
    v_add_f32_dpp v22, v22, v22 row_ror:8 row_mask:0xf bank_mask:0x3
    v_add_f32_dpp v23, v23, v23 row_ror:8 row_mask:0xf bank_mask:0x3
    v_add_f32_dpp v16, v24, v24 row_ror:8 row_mask:0xf bank_mask:0xc
    v_add_f32_dpp v17, v25, v25 row_ror:8 row_mask:0xf bank_mask:0xc
    v_add_f32_dpp v18, v26, v26 row_ror:8 row_mask:0xf bank_mask:0xc
    v_add_f32_dpp v19, v27, v27 row_ror:8 row_mask:0xf bank_mask:0xc
    v_add_f32_dpp v20, v28, v28 row_ror:8 row_mask:0xf bank_mask:0xc
    v_add_f32_dpp v21, v29, v29 row_ror:8 row_mask:0xf bank_mask:0xc
    v_add_f32_dpp v22, v30, v30 row_ror:8 row_mask:0xf bank_mask:0xc
    v_add_f32_dpp v23, v31, v31 row_ror:8 row_mask:0xf bank_mask:0xc
    v_add_f32_dpp v16, v16, v16 row_shl:4 row_mask:0xf bank_mask:0x5
    v_add_f32_dpp v17, v17, v17 row_shl:4 row_mask:0xf bank_mask:0x5
    v_add_f32_dpp v18, v18, v18 row_shl:4 row_mask:0xf bank_mask:0x5
    v_add_f32_dpp v19, v19, v19 row_shl:4 row_mask:0xf bank_mask:0x5
    v_add_f32_dpp v16, v20, v20 row_shr:4 row_mask:0xf bank_mask:0xa
    v_add_f32_dpp v17, v21, v21 row_shr:4 row_mask:0xf bank_mask:0xa
    v_add_f32_dpp v18, v22, v22 row_shr:4 row_mask:0xf bank_mask:0xa
    v_add_f32_dpp v19, v23, v23 row_shr:4 row_mask:0xf bank_mask:0xa
    v_add_f32_dpp v16, v16, v16 quad_perm:[2,3,0,1] row_mask:0xf bank_mask:0xf
    v_add_f32_dpp v17, v17, v17 quad_perm:[2,3,0,1] row_mask:0xf bank_mask:0xf
    v_add_f32_dpp v18, v18, v18 quad_perm:[2,3,0,1] row_mask:0xf bank_mask:0xf
    v_add_f32_dpp v19, v19, v19 quad_perm:[2,3,0,1] row_mask:0xf bank_mask:0xf
    v_cndmask_b32 v16, v16, v18, s[56:57]
    v_cndmask_b32 v17, v17, v19, s[56:57]
    s_nop 0
    v_add_f32_dpp v16, v16, v16 quad_perm:[1,0,3,2] row_mask:0xf bank_mask:0xf
    v_add_f32_dpp v17, v17, v17 quad_perm:[1,0,3,2] row_mask:0xf bank_mask:0xf
    v_cndmask_b32 v16, v16, v17, s[58:59]
    v_cvt_pk_bf16_f32 v16, v16, v16
    v_and_b32 v16, s35, v16
    v_mul_f32 v16, 0x3db504f3, v16
    v_mov_b32 v17, s32
    v_cvt_pk_bf16_f32 v16, v16, v16
    s_cmp_eq_u32 s63, 1
    v_bfi_b32 v16, s35, v16, v17
    s_cbranch_scc0 L_Apub_slow
    buffer_store_dword v16, v12, s[48:51], s54 offen
L_Apub_done:
    v_mov_b32 v20, 0
    v_mov_b32 v21, 0
    v_mov_b32 v22, 0
    v_mov_b32 v23, 0
    s_waitcnt vmcnt(4)
    buffer_load_dwordx4 v[112:115], v13, s[40:43], s55 offen offset:0 nt
    s_waitcnt vmcnt(4)
    buffer_load_dwordx4 v[116:119], v13, s[40:43], s55 offen offset:2048 nt
    s_add_u32 s55, s55, s47
    s_and_b32 s55, s55, s61
    s_waitcnt vmcnt(4)
    buffer_load_dwordx4 v[120:123], v13, s[40:43], s55 offen offset:0 nt
    s_waitcnt vmcnt(4)
    buffer_load_dwordx4 v[124:127], v13, s[40:43], s55 offen offset:2048 nt
    s_add_u32 s55, s55, s47
    s_and_b32 s55, s55, s61
    s_waitcnt vmcnt(4)
    s_mov_b64 exec, 1
    ds_add_u32 v14, v15 offset:16
    s_mov_b64 exec, -1
    s_waitcnt vmcnt(3)
    buffer_load_dwordx4 v[128:131], v13, s[40:43], s55 offen offset:0 nt
    s_waitcnt vmcnt(3)
    buffer_load_dwordx4 v[132:135], v13, s[40:43], s55 offen offset:2048 nt
    s_add_u32 s55, s55, s47
    s_and_b32 s55, s55, s61
    s_waitcnt vmcnt(3)
    buffer_load_dwordx4 v[136:139], v13, s[40:43], s55 offen offset:0 nt
    s_waitcnt vmcnt(3)
    buffer_load_dwordx4 v[140:143], v13, s[40:43], s55 offen offset:2048 nt
    s_add_u32 s55, s55, s47
    s_and_b32 s55, s55, s61
    s_waitcnt vmcnt(3)
    buffer_load_dwordx4 v[144:147], v13, s[40:43], s55 offen offset:0 nt
    s_waitcnt vmcnt(3)
    buffer_load_dwordx4 v[148:151], v13, s[40:43], s55 offen offset:2048 nt
    s_add_u32 s55, s55, s47
    s_and_b32 s55, s55, s61
    s_waitcnt vmcnt(3)
    buffer_load_dwordx4 v[152:155], v13, s[40:43], s55 offen offset:0 nt
    s_waitcnt vmcnt(3)
    buffer_load_dwordx4 v[156:159], v13, s[40:43], s55 offen offset:2048 nt
    s_mov_b64 exec, 1
    ds_add_u32 v14, v15 offset:20
    s_mov_b64 exec, -1
L_Ap:
    ds_read_b32 v5, v14 offset:24
    s_waitcnt lgkmcnt(0)
    v_cmp_eq_u32 vcc, 0, v5
    s_cbranch_vccz L_Ap_ok
    s_sleep 1
    s_branch L_Ap
L_Ap_ok:
    ds_read_b128 v[32:35], v6 offset:13696
    ds_read_b128 v[36:39], v6 offset:14016
    ds_read_b128 v[40:43], v6 offset:14336
    ds_read_b128 v[44:47], v6 offset:14656
    ds_read_b128 v[48:51], v6 offset:14976
    ds_read_b128 v[52:55], v6 offset:15296
    ds_read_b128 v[56:59], v6 offset:15616
    ds_read_b128 v[60:63], v6 offset:15936
    s_waitcnt lgkmcnt(7)
    v_smfmac_f32_16x16x64_bf16 v[20:23], v[32:35], v[96:103], v4
    s_waitcnt lgkmcnt(6)
    v_smfmac_f32_16x16x64_bf16 v[20:23], v[36:39], v[104:111], v4
    s_waitcnt lgkmcnt(5)
    v_smfmac_f32_16x16x64_bf16 v[20:23], v[40:43], v[112:119], v4
    s_waitcnt lgkmcnt(4)
    v_smfmac_f32_16x16x64_bf16 v[20:23], v[44:47], v[120:127], v4
    s_waitcnt lgkmcnt(3)
    v_smfmac_f32_16x16x64_bf16 v[20:23], v[48:51], v[128:135], v4
    s_waitcnt lgkmcnt(2)
    v_smfmac_f32_16x16x64_bf16 v[20:23], v[52:55], v[136:143], v4
    s_waitcnt vmcnt(2) lgkmcnt(1)
    v_smfmac_f32_16x16x64_bf16 v[20:23], v[56:59], v[144:151], v4
    s_waitcnt vmcnt(0) lgkmcnt(0)
    v_smfmac_f32_16x16x64_bf16 v[20:23], v[60:63], v[152:159], v4
    s_mov_b32 exec_lo, 0x00ff00ff
    s_mov_b32 exec_hi, 0xff00ff00
    s_cmp_ge_u32 s88, 40
    s_nop 4
    ds_write_b128 v7, v[20:23] offset:5888
    s_mov_b64 exec, -1
    s_waitcnt lgkmcnt(0)
    s_barrier
    s_cbranch_scc0 L_F
    s_endpgm
L_Y0:
    s_waitcnt lgkmcnt(0)
    s_load_dword s32, s[26:27], 0
    s_mov_b64 s[48:49], s[26:27]
    s_mov_b32 s50, 0x1f8000
    s_mov_b32 s51, 0x20000
    v_and_b32 v4, 3, v0
    v_mul_u32_u24 v4, 0x5555, v4
    s_mov_b32 s34, 15
    s_mov_b32 s35, 0xffff0000
    v_mov_b32 v14, 256
    v_mov_b32 v15, 1
    s_waitcnt lgkmcnt(0)
    s_barrier
    s_sub_u32 s88, s28, 27
    s_lshl3_add_u32 s88, s88, s29
    s_add_u32 s32, s32, 1
    s_and_b32 s33, s32, 15
    v_mov_b32 v3, s33
    s_mov_b32 s62, 0
    s_branch L_Y
L_P2:
    v_and_b32 v4, 3, v0
    v_mul_u32_u24 v4, 0x5555, v4
    s_mov_b32 s34, 15
    s_mov_b32 s35, 0xffff0000
    v_mov_b32 v14, 256
    v_mov_b32 v15, 1
    v_lshrrev_b32 v11, 2, v0
    v_lshrrev_b32 v9, 4, v0
    v_add_lshl_u32 v11, v11, v9, 4
    s_cmp_lt_u32 s3, 2
    s_cselect_b32 s53, 6, 10
    s_mov_b32 s54, 270336
    s_cmov_b32 s54, 8192
    s_cselect_b32 s42, 9, 7
    s_cselect_b32 s43, 8, 6
    s_lshl_b32 s42, s29, s42
    s_add_u32 s54, s54, s42
    s_and_b32 s42, s3, 1
    s_lshl_b32 s42, s42, s43
    s_add_u32 s54, s54, s42
    s_lshl_b32 s42, s28, 13
    s_add_u32 s61, s54, s42
    v_lshrrev_b32 v12, 5, v0
    v_lshlrev_b32 v12, 12, v12
    v_and_b32 v9, 3, v0
    v_lshl_add_u32 v12, v9, 4, v12
    v_bfe_u32 v9, v0, 4, 1
    v_bfe_u32 v8, v0, 2, 1
    v_lshl_add_u32 v9, v9, 1, v8
    v_lshl_add_u32 v36, v9, s53, v12
    s_mov_b32 s62, 1
    v_mov_b32 v28, 0
    v_mov_b32 v29, 0
    v_mov_b32 v30, 0
    v_mov_b32 v31, 0
    v_mov_b32 v32, 0
    v_mov_b32 v33, 0
    v_mov_b32 v34, 0
    v_mov_b32 v35, 0
    s_waitcnt lgkmcnt(0)
    s_barrier
    ds_read_b128 v[80:83], v11 offset:640
    ds_read_b128 v[84:87], v11 offset:2240
    ds_read_b128 v[88:91], v11 offset:960
    ds_read_b128 v[92:95], v11 offset:2560
    ds_read_b128 v[96:99], v11 offset:1280
    ds_read_b128 v[100:103], v11 offset:2880
    ds_read_b128 v[104:107], v11 offset:1600
    ds_read_b128 v[108:111], v11 offset:3200
    ds_read_b128 v[112:115], v11 offset:1920
    ds_read_b128 v[116:119], v11 offset:3520
    s_sub_u32 s88, s28, 27
    s_lshl3_add_u32 s88, s88, s29
    s_add_u32 s32, s32, 1
    s_and_b32 s33, s32, 15
    v_mov_b32 v3, s33
    s_waitcnt vmcnt(8) lgkmcnt(0)
    v_smfmac_f32_16x16x64_bf16 v[32:35], v[80:83], v[40:47], v4
    v_smfmac_f32_16x16x64_bf16 v[28:31], v[84:87], v[40:47], v4
    s_waitcnt vmcnt(6)
    v_smfmac_f32_16x16x64_bf16 v[32:35], v[88:91], v[48:55], v4
    v_smfmac_f32_16x16x64_bf16 v[28:31], v[92:95], v[48:55], v4
    s_waitcnt vmcnt(4)
    v_smfmac_f32_16x16x64_bf16 v[32:35], v[96:99], v[56:63], v4
    v_smfmac_f32_16x16x64_bf16 v[28:31], v[100:103], v[56:63], v4
    s_waitcnt vmcnt(2)
    v_smfmac_f32_16x16x64_bf16 v[32:35], v[104:107], v[64:71], v4
    v_smfmac_f32_16x16x64_bf16 v[28:31], v[108:111], v[64:71], v4
    s_waitcnt vmcnt(0)
    v_smfmac_f32_16x16x64_bf16 v[32:35], v[112:115], v[72:79], v4
    v_smfmac_f32_16x16x64_bf16 v[28:31], v[116:119], v[72:79], v4
    s_nop 7
    v_permlane32_swap_b32 v32, v28
    v_permlane32_swap_b32 v33, v29
    v_permlane32_swap_b32 v34, v30
    v_permlane32_swap_b32 v35, v31
    v_add_f32_dpp v32, v28, v32 row_ror:8 row_mask:0xf bank_mask:0xf
    v_add_f32_dpp v33, v29, v33 row_ror:8 row_mask:0xf bank_mask:0xf
    v_add_f32_dpp v34, v30, v34 row_ror:8 row_mask:0xf bank_mask:0xf
    v_add_f32_dpp v35, v31, v35 row_ror:8 row_mask:0xf bank_mask:0xf
    v_bfi_b32 v32, s34, v3, v32
    v_bfi_b32 v33, s34, v3, v33
    v_bfi_b32 v34, s34, v3, v34
    v_bfi_b32 v35, s34, v3, v35
    s_mov_b32 exec_lo, 0x00ff00ff
    s_mov_b32 exec_hi, 0x00ff00ff
    buffer_store_dwordx4 v[32:35], v36, s[48:51], s61 offen
    s_mov_b64 exec, -1
    s_cmp_lt_u32 s3, 2
    s_cbranch_scc0 L_U
    s_waitcnt vmcnt(0)
    s_mov_b64 exec, 1
    ds_add_u32 v14, v15 offset:28
    s_mov_b64 exec, -1
L_Y:
    s_mov_b64 s[36:37], s[12:13]
    s_mov_b32 s38, 0x500000
    s_mov_b32 s39, 0x20000
    s_mov_b64 s[44:45], s[20:21]
    s_mov_b32 s46, 0x21c000
    s_mov_b32 s47, 0x20000
    v_lshrrev_b32 v8, 4, v0
    v_and_b32 v9, 15, v0
    v_mul_u32_u24 v10, 10240, v8
    v_lshl_add_u32 v37, v9, 4, v10
    v_add_u32 v10, v10, v37
    v_lshlrev_b32 v12, 2, v0
    s_mul_i32 s52, s3, 1152
    s_add_u32 s52, s52, 7936
    v_mov_b32 v24, 0
    v_mov_b32 v25, 0
    v_mov_b32 v26, 0
    v_mov_b32 v27, 0
    v_add_u32 v38, s52, v2
    ds_write_b128 v38, v[24:27]
    ds_write_b128 v38, v[24:27] offset:128
    v_lshlrev_b32 v38, 6, v9
    v_lshrrev_b32 v11, 1, v9
    v_lshl_add_u32 v38, v11, 4, v38
    v_lshrrev_b32 v11, 5, v0
    v_lshl_add_u32 v38, v11, 5, v38
    v_and_b32 v11, 1, v8
    v_lshl_add_u32 v38, v11, 3, v38
    v_add_u32 v38, s52, v38
    v_bfe_u32 v11, v0, 2, 1
    v_lshlrev_b32 v11, 4, v11
    v_lshl_add_u32 v11, v8, 5, v11
    v_add_u32 v39, s52, v11
    v_lshrrev_b32 v13, 2, v9
    v_mul_u32_u24 v13, 20736, v13
    v_lshl_add_u32 v13, v8, 6, v13
    v_and_b32 v9, 3, v9
    v_lshl_add_u32 v13, v9, 4, v13
    s_lshl_b32 s40, s28, 7
    s_and_b32 s52, s31, 1
    s_lshl_b32 s41, s52, 6
    s_add_u32 s40, s40, s41
    s_mul_i32 s40, s40, 1280
    s_lshl_b32 s42, s3, 8
    s_add_u32 s40, s40, s42
    s_lshl_b32 s41, s28, 6
    s_lshl_b32 s52, s52, 5
    s_add_u32 s41, s41, s52
    s_lshr_b32 s52, s31, 1
    s_lshl_b32 s52, s52, 2
    s_add_u32 s41, s41, s52
    s_mul_i32 s41, s41, 1280
    s_add_u32 s41, s41, s42
    s_mul_i32 s55, s30, 20
    s_lshl2_add_u32 s55, s3, s55
    s_mul_i32 s54, s55, 20736
    s_and_b32 s52, s2, 7
    s_lshr_b32 s56, s2, 6
    s_lshl2_add_u32 s53, s56, s31
    s_lshl_b32 s53, s53, 7
    s_add_u32 s54, s54, s53
    s_lshl_b32 s53, s52, 11
    s_add_u32 s63, s54, s53
    s_add_u32 s63, s63, 753664
    s_add_u32 s54, s54, 770048
    s_lshr_b32 s55, s55, 3
    s_lshl_b32 s55, s55, 2
    s_lshr_b32 s55, 0x76543, s55
    s_and_b32 s55, s55, 7
    s_cmp_eq_u32 s55, s52
    s_cselect_b32 s55, 1, 0
    s_cmp_ge_u32 s28, 27
    s_cselect_b32 s46, 0, s46
L_Yg1:
    ds_read_b32 v5, v14 offset:8
    s_waitcnt lgkmcnt(0)
    v_cmp_gt_u32 vcc, 4, v5
    s_cbranch_vccz L_Yg1_ok
    s_sleep 2
    s_branch L_Yg1
L_Yg1_ok:
    buffer_load_dwordx4 v[56:59], v10, s[36:39], s40 offen offset:0 nt
    buffer_load_dwordx4 v[60:63], v10, s[36:39], s40 offen offset:1280 nt
    buffer_load_dwordx4 v[64:67], v10, s[36:39], s40 offen offset:2560 nt
    s_waitcnt vmcnt(2)
    buffer_load_dwordx4 v[68:71], v10, s[36:39], s40 offen offset:3840 nt
    s_addk_i32 s40, 5120
    s_waitcnt vmcnt(2)
    buffer_load_dwordx4 v[72:75], v10, s[36:39], s40 offen offset:0 nt
    s_waitcnt vmcnt(2)
    buffer_load_dwordx4 v[76:79], v10, s[36:39], s40 offen offset:1280 nt
    s_waitcnt vmcnt(2)
    buffer_load_dwordx4 v[80:83], v10, s[36:39], s40 offen offset:2560 nt
    s_waitcnt vmcnt(2)
    buffer_load_dwordx4 v[84:87], v10, s[36:39], s40 offen offset:3840 nt
    s_addk_i32 s40, 5120
    s_waitcnt vmcnt(2)
    buffer_load_dwordx4 v[88:91], v10, s[36:39], s40 offen offset:0 nt
    s_waitcnt vmcnt(2)
    buffer_load_dwordx4 v[92:95], v10, s[36:39], s40 offen offset:1280 nt
    s_waitcnt vmcnt(2)
    buffer_load_dwordx4 v[96:99], v10, s[36:39], s40 offen offset:2560 nt
    s_waitcnt vmcnt(2)
    buffer_load_dwordx4 v[100:103], v10, s[36:39], s40 offen offset:3840 nt
    s_addk_i32 s40, 5120
    s_waitcnt vmcnt(2)
    buffer_load_dwordx4 v[104:107], v10, s[36:39], s40 offen offset:0 nt
    s_waitcnt vmcnt(2)
    buffer_load_dwordx4 v[108:111], v10, s[36:39], s40 offen offset:1280 nt
    s_waitcnt vmcnt(2)
    buffer_load_dwordx4 v[112:115], v10, s[36:39], s40 offen offset:2560 nt
    s_cmp_eq_u32 s62, 0
    s_cbranch_scc1 L_Yver_done
L_Yver:
    ds_read_b32 v5, v14 offset:12
    s_waitcnt lgkmcnt(0)
    v_cmp_eq_u32 vcc, 0, v5
    s_cbranch_vccz L_Yver_ok
    s_sleep 2
    s_branch L_Yver
L_Yver_ok:
    v_cmp_eq_u32 vcc, 2, v5
    s_cbranch_vccnz L_Yver_rep
L_Yver_done:
L_Yg2:
    ds_read_b32 v5, v14 offset:20
    s_waitcnt lgkmcnt(0)
    v_cmp_gt_u32 vcc, 4, v5
    s_cbranch_vccz L_Yg2_ok
    s_sleep 1
    s_branch L_Yg2
L_Yg2_ok:
    buffer_load_dwordx4 v[116:119], v10, s[36:39], s40 offen offset:3840 nt
    buffer_load_dwordx4 v[40:43], v37, s[44:47], s41 offen offset:0 nt
    buffer_load_dwordx4 v[44:47], v37, s[44:47], s41 offen offset:1280 nt
    buffer_load_dwordx4 v[48:51], v37, s[44:47], s41 offen offset:2560 nt
    buffer_load_dwordx4 v[52:55], v37, s[44:47], s41 offen offset:3840 nt
    s_cmp_ge_u32 s28, 27
    s_cbranch_scc1 L_Yh_ok
L_Yh:
    ds_read_b32 v5, v14 offset:4
    s_waitcnt lgkmcnt(0)
    v_cmp_eq_u32 vcc, 0, v5
    s_cbranch_vccz L_Yh_ok
    s_sleep 1
    s_branch L_Yh
L_Yh_ok:
    ds_read_b128 v[152:155], v11 offset:320
    ds_read_b128 v[156:159], v11 offset:464
    s_barrier
    ds_read2st64_b32 v[16:17], v12 offset0:23 offset1:24
    ds_read2st64_b32 v[18:19], v12 offset0:25 offset1:26
    ds_read2st64_b32 v[20:21], v12 offset0:27 offset1:28
    ds_read2st64_b32 v[22:23], v12 offset0:29 offset1:30
    ds_read_b32 v5, v14 offset:36
    s_waitcnt lgkmcnt(0)
    v_pk_add_f32 v[16:17], v[16:17], v[18:19]
    v_pk_add_f32 v[20:21], v[20:21], v[22:23]
    v_pk_add_f32 v[16:17], v[16:17], v[20:21]
    v_add_f32 v16, v16, v17
    v_mul_f32 v16, v16, v5
    v_cvt_pk_bf16_f32 v16, v16, 0
    ds_write2_b32 v38, v16, v16 offset0:0 offset1:5
    ds_read_b128 v[120:123], v39 offset:0
    ds_read_b128 v[124:127], v39 offset:144
    ds_read_b128 v[128:131], v39 offset:288
    ds_read_b128 v[132:135], v39 offset:432
    ds_read_b128 v[136:139], v39 offset:576
    ds_read_b128 v[140:143], v39 offset:720
    ds_read_b128 v[144:147], v39 offset:864
    ds_read_b128 v[148:151], v39 offset:1008
    s_waitcnt lgkmcnt(7)
    v_smfmac_f32_16x16x64_bf16 v[24:27], v[120:123], v[56:63], v4
    s_waitcnt lgkmcnt(6)
    v_smfmac_f32_16x16x64_bf16 v[24:27], v[124:127], v[64:71], v4
    s_waitcnt lgkmcnt(5)
    v_smfmac_f32_16x16x64_bf16 v[24:27], v[128:131], v[72:79], v4
    s_waitcnt lgkmcnt(4)
    v_smfmac_f32_16x16x64_bf16 v[24:27], v[132:135], v[80:87], v4
    s_waitcnt lgkmcnt(3)
    v_smfmac_f32_16x16x64_bf16 v[24:27], v[136:139], v[88:95], v4
    s_waitcnt lgkmcnt(2)
    v_smfmac_f32_16x16x64_bf16 v[24:27], v[140:143], v[96:103], v4
    s_waitcnt vmcnt(6) lgkmcnt(1)
    v_smfmac_f32_16x16x64_bf16 v[24:27], v[144:147], v[104:111], v4
    s_waitcnt vmcnt(4) lgkmcnt(0)
    v_smfmac_f32_16x16x64_bf16 v[24:27], v[148:151], v[112:119], v4
    s_waitcnt vmcnt(2)
    v_smfmac_f32_16x16x64_bf16 v[24:27], v[152:155], v[40:47], v4
    s_waitcnt vmcnt(0)
    v_smfmac_f32_16x16x64_bf16 v[24:27], v[156:159], v[48:55], v4
    s_mov_b32 exec_hi, 0
    s_cmp_eq_u32 s55, 0
    s_nop 5
    v_bfi_b32 v24, s34, v3, v24
    v_bfi_b32 v25, s34, v3, v25
    v_bfi_b32 v26, s34, v3, v26
    v_bfi_b32 v27, s34, v3, v27
    s_cbranch_scc1 L_Ypb
    buffer_store_dwordx4 v[24:27], v13, s[48:51], s54 offen
L_Ypb:
    buffer_store_dwordx4 v[24:27], v13, s[48:51], s63 offen sc1
    s_cmp_ge_u32 s88, 40
    s_cbranch_scc1 L_Yend
    s_mov_b64 exec, -1
    s_add_u32 s3, s3, 4
    s_cmp_lt_u32 s3, 8
    s_cbranch_scc1 L_F
    s_barrier
L_Yend:
    s_endpgm
L_U:
    s_mov_b32 s60, 0
L_Uver:
    ds_read_b32 v5, v14 offset:12
    s_waitcnt lgkmcnt(0)
    v_cmp_eq_u32 vcc, 0, v5
    s_cbranch_vccz L_Uver_ok
    s_sleep 2
    s_branch L_Uver
L_Uver_ok:
    v_cmp_eq_u32 vcc, 2, v5
    s_cbranch_vccnz L_Uver_rep
L_Uver_done:
    s_cmp_lg_u32 s3, 2
    s_cbranch_scc1 L_Uend
    s_waitcnt vmcnt(0)
    s_lshl_b32 s54, s28, 13
    s_lshl_b32 s42, s29, 10
    s_add_u32 s54, s54, s42
    s_add_u32 s54, s54, 270336
    v_lshrrev_b32 v12, 4, v0
    v_lshlrev_b32 v12, 6, v12
    v_lshrrev_b32 v9, 5, v0
    v_lshl_add_u32 v12, v9, 4, v12
    v_bfe_u32 v9, v0, 1, 1
    v_lshl_add_u32 v12, v9, 5, v12
    v_and_b32 v9, 1, v0
    v_lshl_add_u32 v12, v9, 3, v12
L_Gh_p:
    buffer_load_dwordx4 v[40:43], v2, s[48:51], s54 offen nt
L_Gh_c:
    s_waitcnt vmcnt(0)
    v_xor_b32 v40, v40, v3
    v_xor_b32 v41, v41, v3
    v_xor_b32 v42, v42, v3
    v_xor_b32 v43, v43, v3
    v_or_b32 v16, v40, v41
    v_or3_b32 v16, v42, v43, v16
    v_and_b32 v16, s34, v16
    v_cmp_ne_u32 vcc, 0, v16
    s_cbranch_vccnz L_Gh_f
L_Gh_ok:
    s_nop 1
    v_permlane32_swap_b32 v40, v42
    v_permlane32_swap_b32 v41, v43
    v_add_f32 v40, v40, v42
    v_add_f32 v41, v41, v43
    s_nop 1
    v_permlane16_swap_b32 v40, v41
    v_add_f32 v40, v40, v41
    s_nop 1
    v_add_f32_dpp v40, v40, v40 row_ror:8 row_mask:0xf bank_mask:0xf
    v_cvt_pk_bf16_f32 v40, v40, v40
    v_and_b32 v40, s35, v40
    v_mul_f32 v41, v40, v40
    v_mov_b32 v42, 0x3d372713
    v_fma_f32 v41, v41, v42, 1.0
    v_mul_f32 v41, v41, v40
    v_mul_f32 v41, 0xc0135761, v41
    v_exp_f32 v41, v41
    s_nop 0
    v_add_f32 v41, 1.0, v41
    v_rcp_f32 v41, v41
    s_nop 0
    v_mul_f32 v41, v41, v40
    v_cvt_pk_bf16_f32 v41, v41, v41
    v_and_b32 v41, s35, v41
    s_nop 1
    v_mul_f32_dpp v41, v40, v41 row_shl:4 row_mask:0xf bank_mask:0xf bound_ctrl:0
    v_cvt_pk_bf16_f32 v41, v41, 0
    s_mov_b32 exec_lo, 0x000f000f
    s_mov_b32 exec_hi, 0x000f000f
    ds_write2_b32 v12, v41, v41 offset0:80 offset1:85
    ds_write_b32 v14, v15 offset:4
L_Uend:
    s_endpgm
L_Uskip:
    s_endpgm
L_F:
    s_mov_b32 s52, s88
    s_mul_i32 s54, s52, 20736
    s_lshl_b32 s53, s3, 11
    s_add_u32 s63, s54, s53
    s_add_u32 s63, s63, 753664
    s_add_u32 s54, s54, 770048
    s_and_b32 s53, s2, 7
    s_cmp_eq_u32 s53, s3
    s_cselect_b32 s57, 1, 0
    s_lshl_b32 s55, s52, 6
    s_mov_b32 s60, 0
    v_and_b32 v12, 7, v0
    v_lshrrev_b32 v9, 4, v0
    v_lshl_add_u32 v12, v9, 3, v12
    v_mul_u32_u24 v12, 48, v12
    s_lshl_b32 s53, s3, 2
    v_add_u32 v12, s53, v12
    s_mov_b64 s[36:37], s[4:5]
    s_mov_b32 s38, 0xa00
    s_mov_b32 s39, 0x20000
    s_mov_b64 s[40:41], s[22:23]
    s_mov_b32 s42, 0xa00
    s_mov_b32 s43, 0x20000
    v_mul_u32_u24 v11, 48, v0
    v_and_b32 v13, 3, v0
    v_lshlrev_b32 v13, 4, v13
    v_bfe_u32 v9, v0, 2, 1
    v_lshl_add_u32 v13, v9, 3, v13
    v_bfe_u32 v9, v0, 3, 2
    v_lshl_add_u32 v13, v9, 1, v13
    s_mov_b32 exec_hi, 0
    buffer_load_ushort v30, v13, s[36:39], s55 offen
    s_mov_b64 exec, -1
L_F_b:
    s_barrier
    s_cmp_eq_u32 s57, 1
    s_cbranch_scc1 L_F_li0
    buffer_load_dwordx4 v[48:51], v2, s[48:51], s63 offen offset:0 sc1
    buffer_load_dwordx4 v[52:55], v2, s[48:51], s63 offen offset:1024 sc1
L_F_ri0:
L_F_p:
    s_cmp_eq_u32 s57, 1
    s_cbranch_scc1 L_F_lm0
    buffer_load_dwordx4 v[56:59], v2, s[48:51], s63 offen offset:0 sc1
    buffer_load_dwordx4 v[60:63], v2, s[48:51], s63 offen offset:1024 sc1
L_F_rm0:
    s_waitcnt vmcnt(2)
    v_xor_b32 v48, v48, v3
    v_xor_b32 v49, v49, v3
    v_xor_b32 v50, v50, v3
    v_xor_b32 v51, v51, v3
    v_xor_b32 v52, v52, v3
    v_xor_b32 v53, v53, v3
    v_xor_b32 v54, v54, v3
    v_xor_b32 v55, v55, v3
    v_or_b32 v16, v48, v49
    v_or3_b32 v16, v50, v51, v16
    v_or3_b32 v16, v52, v53, v16
    v_or3_b32 v16, v54, v55, v16
    v_and_b32 v16, s34, v16
    v_pk_add_f32 v[40:41], v[48:49], v[52:53]
    v_pk_add_f32 v[42:43], v[50:51], v[54:55]
    v_cmp_ne_u32 vcc, 0, v16
    s_cbranch_vccz L_F_ok
    s_cmp_eq_u32 s57, 1
    s_cbranch_scc1 L_F_lm1
    buffer_load_dwordx4 v[48:51], v2, s[48:51], s63 offen offset:0 sc1
    buffer_load_dwordx4 v[52:55], v2, s[48:51], s63 offen offset:1024 sc1
L_F_rm1:
    s_waitcnt vmcnt(2)
    v_xor_b32 v56, v56, v3
    v_xor_b32 v57, v57, v3
    v_xor_b32 v58, v58, v3
    v_xor_b32 v59, v59, v3
    v_xor_b32 v60, v60, v3
    v_xor_b32 v61, v61, v3
    v_xor_b32 v62, v62, v3
    v_xor_b32 v63, v63, v3
    v_or_b32 v16, v56, v57
    v_or3_b32 v16, v58, v59, v16
    v_or3_b32 v16, v60, v61, v16
    v_or3_b32 v16, v62, v63, v16
    v_and_b32 v16, s34, v16
    v_pk_add_f32 v[40:41], v[56:57], v[60:61]
    v_pk_add_f32 v[42:43], v[58:59], v[62:63]
    v_cmp_ne_u32 vcc, 0, v16
    s_cbranch_vccz L_F_ok
    s_add_u32 s60, s60, 2
    s_cmp_ge_u32 s60, 200
    s_cselect_b32 s57, 0, s57
    s_cmp_lt_u32 s60, 65536
    s_cbranch_scc1 L_F_p
L_F_ok:
    v_permlane32_swap_b32 v40, v42
    v_permlane32_swap_b32 v41, v43
    v_add_f32 v40, v40, v42
    v_add_f32 v41, v41, v43
    s_nop 1
    v_permlane16_swap_b32 v40, v41
    v_add_f32 v40, v40, v41
    s_nop 1
    v_add_f32_dpp v40, v40, v40 row_ror:8 row_mask:0xf bank_mask:0xf
    s_mov_b32 exec_lo, 0x00ff00ff
    s_mov_b32 exec_hi, 0x00ff00ff
    ds_write_b32 v12, v40 offset:4352
    s_mov_b64 exec, 1
    ds_add_rtn_u32 v5, v14, v15 offset:40
    s_mov_b32 exec_lo, -1
    ds_read_b128 v[40:43], v11 offset:4352
    ds_read_b128 v[44:47], v11 offset:4368
    v_lshlrev_b32 v30, 16, v30
    s_waitcnt lgkmcnt(0)
    v_readfirstlane_b32 s56, v5
    s_cmp_lg_u32 s56, 7
    s_cbranch_scc1 L_fin3
    s_cmp_lg_u32 s52, 0
    v_pk_add_f32 v[40:41], v[40:41], v[42:43]
    v_pk_add_f32 v[44:45], v[44:45], v[46:47]
    v_pk_add_f32 v[40:41], v[40:41], v[44:45]
    v_add_f32 v40, v40, v41
    v_add_f32 v40, v40, v30
    v_cvt_pk_bf16_f32 v40, v40, v40
    buffer_store_short v40, v13, s[40:43], s55 offen
    s_cbranch_scc1 L_fin2
    v_mov_b32 v33, s32
    v_lshlrev_b32 v34, 2, v0
    buffer_store_dword v33, v34, s[48:51], 0 offen
L_fin2:
L_fin3:
    s_endpgm
L_Gq_f:
    s_add_u32 s60, s60, 1
    s_cmp_lt_u32 s60, 200
    s_cbranch_scc1 L_Gq_p
    s_cmp_ge_u32 s60, 65536
    s_cbranch_scc1 L_Gq_ok
    s_mov_b32 s53, 0
    v_mov_b32 v15, 2
    ds_write_b32 v14, v15 offset:12
    buffer_load_dwordx4 v[40:43], v2, s[48:51], s54 offen offset:0 sc1
    buffer_load_dwordx4 v[44:47], v2, s[48:51], s54 offen offset:1024 sc1
    buffer_load_dwordx4 v[48:51], v2, s[48:51], s54 offen offset:2048 sc1
    buffer_load_dwordx4 v[52:55], v2, s[48:51], s54 offen offset:3072 sc1
    buffer_load_dword v56, v13, s[48:51], s55 offen sc1
    s_branch L_Gq_c
L_Gs_f:
    s_add_u32 s60, s60, 1
    s_cmp_lt_u32 s60, 200
    s_cbranch_scc1 L_Gs_p
    s_cmp_ge_u32 s60, 65536
    s_cbranch_scc1 L_Gs_ok
    buffer_load_dwordx4 v[40:43], v2, s[48:51], s57 offen offset:0 sc1
    buffer_load_dwordx4 v[44:47], v2, s[48:51], s57 offen offset:1024 sc1
    buffer_load_dwordx4 v[48:51], v2, s[48:51], s56 offen offset:0 sc1
    buffer_load_dwordx4 v[52:55], v2, s[48:51], s56 offen offset:1024 sc1
    s_branch L_Gs_c
L_Apub_slow:
    buffer_store_dword v16, v12, s[48:51], s54 offen sc1
    s_branch L_Apub_done
L_Yver_rep:
    s_mov_b32 exec_lo, 0x00ff00ff
    s_mov_b32 exec_hi, 0x00ff00ff
    buffer_store_dwordx4 v[32:35], v36, s[48:51], s61 offen sc1
    s_mov_b64 exec, -1
    s_branch L_Yver_done
L_Uver_rep:
    s_mov_b32 exec_lo, 0x00ff00ff
    s_mov_b32 exec_hi, 0x00ff00ff
    buffer_store_dwordx4 v[32:35], v36, s[48:51], s61 offen sc1
    s_mov_b64 exec, -1
    s_movk_i32 s60, 200
    s_branch L_Uver_done
L_Gh_f:
    s_add_u32 s60, s60, 1
    s_cmp_lt_u32 s60, 200
    s_cbranch_scc1 L_Gh_p
    s_cmp_ge_u32 s60, 65536
    s_cbranch_scc1 L_Gh_ok
    buffer_load_dwordx4 v[40:43], v2, s[48:51], s54 offen sc1
    s_branch L_Gh_c
L_F_li0:
    buffer_load_dwordx4 v[48:51], v2, s[48:51], s54 offen offset:0 nt
    buffer_load_dwordx4 v[52:55], v2, s[48:51], s54 offen offset:1024 nt
    s_branch L_F_ri0
L_F_lm0:
    buffer_load_dwordx4 v[56:59], v2, s[48:51], s54 offen offset:0 nt
    buffer_load_dwordx4 v[60:63], v2, s[48:51], s54 offen offset:1024 nt
    s_branch L_F_rm0
L_F_lm1:
    buffer_load_dwordx4 v[48:51], v2, s[48:51], s54 offen offset:0 nt
    buffer_load_dwordx4 v[52:55], v2, s[48:51], s54 offen offset:1024 nt
    s_branch L_F_rm1
L_end:
    s_endpgm
L_codeend:

.section .rodata,"a"
.p2align 6
.amdhsa_kernel parallel_sum__sliding_block_cached__geglu_ffn__decode_kernel
  .amdhsa_next_free_vgpr 164
  .amdhsa_next_free_sgpr 96
  .amdhsa_accum_offset 164
  .amdhsa_group_segment_fixed_size 0
  .amdhsa_kernarg_size 96
  .amdhsa_user_sgpr_count 2
  .amdhsa_user_sgpr_kernarg_segment_ptr 1
  .amdhsa_system_sgpr_workgroup_id_x 1
  .amdhsa_float_denorm_mode_32 3
  .amdhsa_float_denorm_mode_16_64 3
  .amdhsa_ieee_mode 0
  .amdhsa_dx10_clamp 0
.end_amdhsa_kernel
```
